```python
import torch

def _softmax(x, axis=-1):
    return torch.softmax(x, dim=axis)
def _gelu(x):
    return torch.nn.functional.gelu(x, approximate="tanh")
def _silu(x):
    return torch.nn.functional.silu(x)
def _sigmoid(x):
    return torch.sigmoid(x)
def _layernorm(x, axis=-1, eps=1e-5):
    m = x.mean(dim=axis, keepdim=True)
    v = x.var(dim=axis, keepdim=True, unbiased=False)
    return (x - m) / torch.sqrt(v + eps)
def _scatter_add(tgt, idx, src, axis=0):
    return tgt.clone().index_add_(axis, idx, src)
def _segment_sum(src, seg, n):
    out = torch.zeros((n,) + src.shape[1:], dtype=src.dtype)
    return out.index_add_(0, seg, src)
def _pad(x, pw):
    flat = tuple(v for pair in reversed(pw) for v in pair)
    return torch.nn.functional.pad(x, flat)

kernel_name = 'standalone__paged_block_table_kv_pagedattention__sampling'

def setup_inputs():

    _w = (lambda a: (lambda t: t.to(torch.bfloat16) if t.is_floating_point() else t)(torch.as_tensor(a)))
    B, Hq, Hkv, Sq, Skv, D = 16, 32, 32, 32, 2048, 128
    bs = 16
    nbps = max(1, Skv // bs)
    num_phys = B * nbps + 4
    bt = torch.randperm(num_phys)[: B * nbps].reshape(B, nbps).to(torch.int64)
    cl = (nbps * bs - (torch.arange(1, B + 1, dtype=torch.int64) * 2654435761) % max(1, nbps * bs // 2)).to(torch.int64)
    return {
        "q": _w((lambda *s: torch.randn(*s, dtype=torch.bfloat16) * 0.8)(B, Hq, Sq, D)),
        "k_cache": _w((lambda *s: torch.randn(*s, dtype=torch.bfloat16) * 0.8)(num_phys, bs, Hkv, D)),
        "v_cache": _w((lambda *s: torch.randn(*s, dtype=torch.bfloat16) * 0.05)(num_phys, bs, Hkv, D)),
        "block_table": _w(bt),
        "context_lens": _w(cl),
    }

def reference(q, k_cache, v_cache, block_table, context_lens):
    B, Hq, Sq, D = q.shape
    bs = k_cache.shape[1]
    Hkv = k_cache.shape[2]
    nbps = block_table.shape[1]
    Skv = nbps * bs
    bt = block_table.reshape(-1)
    k = (lambda x, *d: x.permute(*d))(k_cache[bt].reshape(B, Skv, Hkv, D), 0, 2, 1, 3)
    v = (lambda x, *d: x.permute(*d))(v_cache[bt].reshape(B, Skv, Hkv, D), 0, 2, 1, 3)
    g = Hq // Hkv
    qg = q.reshape(B, Hkv, g, Sq, D)
    scores = torch.einsum("bhgqd,bhkd->bhgqk", qg, k) * (D ** -0.5)
    pos = torch.arange(Skv)
    msk = pos[None, :] < context_lens[:, None]
    scores = torch.where(msk[:, None, None, None, :], scores, -1e9)
    p = _softmax(scores, axis=-1)
    out = torch.einsum("bhgqk,bhkd->bhgqd", p, v)
    return out.reshape(B, Hq, Sq, D)
```

```asm
; @launch grid=(256,1,1) block=(256,1,1) lds=131136
.amdgcn_target "amdgcn-amd-amdhsa--gfx950"
.text
.globl standalone__paged_block_table_kv_pagedattention__sampling_kernel
.p2align 8
.type standalone__paged_block_table_kv_pagedattention__sampling_kernel,@function
standalone__paged_block_table_kv_pagedattention__sampling_kernel:
    s_cmpk_ge_u32 s2, 256
    s_cbranch_scc1 L_end
    s_load_dwordx16 s[4:19], s[0:1], 0
    v_readfirstlane_b32 s3, v0
    s_and_b32 s20, s2, 7
    s_lshr_b32 s21, s2, 3
    s_lshl_b32 s20, s20, 2
    s_sub_u32 s44, s3, 64
    s_cmpk_lt_u32 s44, 128
    s_cbranch_scc0 L_other
    s_mov_b32 s36, 0xa35fd861
    s_cmp_eq_u32 s44, 0
    s_cselect_b32 s36, 0x7ce42b9, s36
    s_cselect_b32 s37, 0, 3
    s_xor_b32 s21, s21, s37
    s_lshr_b32 s36, s36, s20
    s_and_b32 s36, s36, 15
    s_lshl_b32 s45, s36, 5
    s_add_u32 s45, s45, s21
    s_lshl_b32 s45, s45, 13
    v_and_b32 v7, 15, v0
    v_bfe_u32 v8, v0, 4, 2
    v_xor_b32 v9, v7, v8
    v_lshlrev_b32 v8, 8, v8
    v_lshl_add_u32 v9, v9, 4, v8
    s_lshl_b32 s44, s44, 10
    s_add_u32 m0, s44, 0xe000
    v_xor_b32 v10, 64, v9
    v_xor_b32 v11, 0x80, v9
    v_xor_b32 v12, 64, v11
    s_movk_i32 s30, 0x2000
    s_mov_b32 s31, 0x20000
    s_waitcnt lgkmcnt(0)
    s_add_u32 s28, s4, s45
    s_addc_u32 s29, s5, 0
    buffer_load_dwordx4 v9, s[28:31], 0 offen offset:0 nt lds
    buffer_load_dwordx4 v10, s[28:31], 0 offen offset:1024 nt lds
    buffer_load_dwordx4 v11, s[28:31], 0 offen offset:2048 nt lds
    buffer_load_dwordx4 v12, s[28:31], 0 offen offset:3072 nt lds
    s_add_u32 m0, s44, 0xf000
    s_movk_i32 s47, 0x1000
    buffer_load_dwordx4 v9, s[28:31], s47 offen offset:0 nt lds
    buffer_load_dwordx4 v10, s[28:31], s47 offen offset:1024 nt lds
    buffer_load_dwordx4 v11, s[28:31], s47 offen offset:2048 nt lds
    buffer_load_dwordx4 v12, s[28:31], s47 offen offset:3072 nt lds
    s_branch L_cons2
.p2align 8
L_other:
    s_cmp_eq_u32 s3, 0
    s_cbranch_scc1 L_loader1
    s_barrier
    s_branch L_ctrl
L_loader1:
    s_lshr_b32 s26, 0x7ce42b9, s20
    s_lshr_b32 s27, 0xa35fd861, s20
    s_and_b32 s26, s26, 15
    s_and_b32 s27, s27, 15
    v_lshlrev_b32 v9, 3, v0
    s_lshl_b32 s22, s26, 9
    s_lshl_b32 s23, s27, 9
    v_add_u32 v10, s22, v9
    v_add_u32 v11, s23, v9
    s_lshl_b32 s24, s26, 2
    s_lshl_b32 s25, s27, 2
    s_waitcnt lgkmcnt(0)
    s_load_dwordx2 s[50:51], s[10:11], s22
    s_load_dwordx2 s[52:53], s[10:11], s23
    s_load_dword s36, s[12:13], s24
    s_load_dword s37, s[12:13], s25
    global_load_dwordx2 v[44:45], v10, s[10:11]
    global_load_dwordx2 v[46:47], v11, s[10:11]
    v_mov_b32 v2, 0
    v_mov_b32 v6, 131072
    ds_write_b32 v6, v2
    v_mov_b32 v3, 2
    ds_write_b32 v6, v3 offset:24
    v_and_b32 v7, 15, v0
    v_lshrrev_b32 v8, 4, v0
    v_lshlrev_b32 v9, 13, v8
    v_lshlrev_b32 v12, 2, v8
    v_xor_b32 v12, v12, v7
    v_lshl_add_u32 v28, v12, 4, v9
    v_xor_b32 v12, v8, v7
    v_lshl_add_u32 v24, v12, 4, v9
L_loader2:
    v_add_u32 v29, 31744, v28
    v_xor_b32 v25, 64, v24
    v_add_u32 v25, 31744, v25
    v_add_u32 v30, 63488, v28
    v_xor_b32 v26, 128, v24
    v_add_u32 v26, 63488, v26
    v_add_u32 v31, 95232, v28
    v_xor_b32 v27, 192, v24
    v_add_u32 v27, 95232, v27
    v_mov_b32 v56, v24
    v_mov_b32 v64, v28
    v_mov_b32 v57, v25
    v_mov_b32 v65, v29
    v_mov_b32 v58, v26
    v_mov_b32 v66, v30
    v_mov_b32 v59, v27
    v_mov_b32 v67, v31
    v_mov_b32 v60, v24
    v_mov_b32 v68, v28
    v_mov_b32 v61, v25
    v_mov_b32 v69, v29
    v_mov_b32 v62, v26
    v_mov_b32 v70, v30
    v_mov_b32 v63, v27
    v_mov_b32 v71, v31
    s_mov_b32 s28, s6
    s_and_b32 s29, s7, 0xffff
    s_mov_b32 s30, 268959744
    s_mov_b32 s31, 0x20000
    s_mov_b32 s32, s8
    s_and_b32 s33, s9, 0xffff
    s_mov_b32 s34, 268959744
    s_mov_b32 s35, 0x20000
    s_lshl_b32 s21, s21, 8
    s_xor_b32 s71, s21, 768
    s_mov_b32 s68, 0x80000000
    s_mov_b32 s40, 0
    s_mov_b32 s41, 0
    s_mov_b32 s59, 0
    s_mov_b32 s60, 0
    s_mov_b32 s61, 0
    s_mov_b32 s62, 2
    s_mov_b32 s74, 31
    s_mov_b32 s75, 31
    s_mov_b32 s64, 0
    s_mov_b32 s65, 0
    s_mov_b32 s66, 0
    s_mov_b32 s67, 0
    s_waitcnt lgkmcnt(0)
    s_sub_u32 s36, s36, 1
    s_min_u32 s36, s36, 0x7ff
    s_sub_u32 s37, s37, 1
    s_min_u32 s37, s37, 0x7ff
    s_min_u32 s63, s36, s37
    s_cmp_lt_u32 s63, 31
    s_cbranch_scc1 L_slow
    s_mov_b32 m0, 0
    s_lshl_b32 s50, s50, 17
    s_add_u32 s50, s50, s21
    buffer_load_dwordx4 v24, s[28:31], s50 offen offset:0 nt lds
    buffer_load_dwordx4 v25, s[28:31], s50 offen offset:1024 nt lds
    buffer_load_dwordx4 v26, s[28:31], s50 offen offset:2048 nt lds
    buffer_load_dwordx4 v27, s[28:31], s50 offen offset:3072 nt lds
    s_mov_b32 m0, 4096
    s_lshl_b32 s51, s51, 17
    s_add_u32 s51, s51, s21
    buffer_load_dwordx4 v24, s[28:31], s51 offen offset:0 nt lds
    buffer_load_dwordx4 v25, s[28:31], s51 offen offset:1024 nt lds
    buffer_load_dwordx4 v26, s[28:31], s51 offen offset:2048 nt lds
    buffer_load_dwordx4 v27, s[28:31], s51 offen offset:3072 nt lds
    s_mov_b32 m0, 65536
    s_lshl_b32 s52, s52, 17
    s_add_u32 s52, s52, s71
    buffer_load_dwordx4 v24, s[28:31], s52 offen offset:0 nt lds
    buffer_load_dwordx4 v25, s[28:31], s52 offen offset:1024 nt lds
    buffer_load_dwordx4 v26, s[28:31], s52 offen offset:2048 nt lds
    buffer_load_dwordx4 v27, s[28:31], s52 offen offset:3072 nt lds
    s_mov_b32 m0, 69632
    s_lshl_b32 s53, s53, 17
    s_add_u32 s53, s53, s71
    buffer_load_dwordx4 v24, s[28:31], s53 offen offset:0 nt lds
    buffer_load_dwordx4 v25, s[28:31], s53 offen offset:1024 nt lds
    buffer_load_dwordx4 v26, s[28:31], s53 offen offset:2048 nt lds
    buffer_load_dwordx4 v27, s[28:31], s53 offen offset:3072 nt lds
    s_mov_b32 s40, 1
    s_mov_b32 s41, 1
    s_mov_b32 s65, 1
    s_mov_b32 s59, 0x10001
    s_mov_b32 s64, s59
L_slow:
    s_barrier
    s_lshr_b32 s38, s36, 5
    s_add_u32 s38, s38, 1
    s_lshr_b32 s39, s37, 5
    s_add_u32 s39, s39, 1
    s_add_u32 s58, s38, s39
    s_add_u32 s58, s58, 2
    s_sub_u32 s57, s39, s38
    s_lshl1_add_u32 s27, s39, 2
    s_lshl1_add_u32 s26, s38, 2
    s_min_u32 s25, s38, s39
    s_min_u32 s25, s25, 2
    s_lshl_b32 s25, s25, 1
    s_sub_u32 s26, s26, s25
    s_sub_u32 s27, s27, s25
    s_sub_u32 s26, 0, s26
    v_add_u32 v34, -1, v0
    s_add_u32 s22, s20, 2
    s_sub_u32 s63, s38, 1
    s_min_u32 s22, s22, s63
    v_cmp_gt_u32 vcc, s22, v0
    v_mov_b32 v35, s63
    s_lshl_b32 s63, s22, 8
    v_cndmask_b32 v32, v34, v0, vcc
    v_cmp_eq_u32 vcc, s22, v0
    s_and_b32 s36, s36, 31
    s_or_b32 s36, s36, s63
    v_cndmask_b32 v32, v32, v35, vcc
    v_lshlrev_b32 v32, 2, v32
    s_xor_b32 s22, s20, 16
    s_lshr_b32 s22, s22, 1
    s_add_u32 s22, s22, 2
    s_sub_u32 s63, s39, 1
    s_min_u32 s22, s22, s63
    v_cmp_gt_u32 vcc, s22, v0
    v_mov_b32 v35, s63
    s_lshl_b32 s63, s22, 8
    v_cndmask_b32 v33, v34, v0, vcc
    v_cmp_eq_u32 vcc, s22, v0
    s_and_b32 s37, s37, 31
    s_or_b32 s37, s37, s63
    v_cndmask_b32 v33, v33, v35, vcc
    v_lshlrev_b32 v33, 2, v33
    s_lshl1_add_u32 s63, s40, 1
    s_mul_i32 s57, s57, s63
    s_sub_u32 s58, s58, s40
    s_sub_u32 s58, s58, s40
    s_cmp_eq_u32 s40, 0
    s_cbranch_scc0 L_w16
    s_waitcnt vmcnt(0)
L_w16:
    s_waitcnt vmcnt(16)
    ds_bpermute_b32 v44, v32, v44
    ds_bpermute_b32 v45, v32, v45
    ds_bpermute_b32 v46, v33, v46
    ds_bpermute_b32 v47, v33, v47
    s_waitcnt lgkmcnt(0)
    v_lshl_add_u32 v44, v44, 17, s21
    v_lshl_add_u32 v45, v45, 17, s21
    v_lshl_add_u32 v46, v46, 17, s71
    v_lshl_add_u32 v47, v47, 17, s71
L_step:
    v_readlane_b32 s42, v44, s40
    v_readlane_b32 s43, v45, s40
    v_readlane_b32 s44, v46, s41
    v_readlane_b32 s45, v47, s41
    s_cmp_eq_u32 s58, s25
    s_cselect_b32 s57, -1, s57
    s_cselect_b32 s26, -2, s26
    s_cselect_b32 s27, 2, s27
    s_cmp_le_i32 s57, 0
    s_cselect_b64 s[46:47], s[42:43], s[44:45]
    s_cselect_b64 s[48:49], s[50:51], s[52:53]
    s_cselect_b64 s[50:51], s[42:43], s[50:51]
    s_cselect_b64 s[52:53], s[52:53], s[44:45]
    s_cselect_b32 s22, s40, s41
    s_cselect_b32 s23, s38, s39
    s_cselect_b32 s72, s36, s37
    s_cselect_b32 s55, 0, 65536
    s_cselect_b32 s56, 1, 0x10000
    s_cselect_b32 s24, s60, s61
    s_cselect_b32 s63, s27, s26
    s_addc_u32 s40, s40, 0
    s_add_u32 s57, s57, s63
    s_lshr_b32 s63, s56, 16
    s_add_u32 s41, s41, s63
    s_lshl_b32 s63, s22, 8
    s_sub_u32 s72, s72, s63
    s_add_u32 s73, s72, 256
    s_min_u32 s72, s72, 31
    s_min_u32 s73, s73, 31
    s_lshl_b32 s63, s22, 14
    s_and_b32 s54, s63, 0xc000
    s_add_u32 s54, s54, s55
    s_sub_u32 s63, s63, 0x2000
    s_and_b32 s63, s63, 0xe000
    s_add_u32 s55, s55, s63
    s_cmp_lg_u64 s[72:73], s[74:75]
    s_cbranch_scc1 L_fix
L_fixed:
    s_sub_u32 s63, s22, 3
    s_cmp_ge_i32 s24, s63
    s_cbranch_scc0 L_spin
L_go:
    s_cmp_eq_u32 s62, 1
    s_cbranch_scc1 L_body1
    s_cmp_eq_u32 s62, 3
    s_cbranch_scc1 L_body3
    s_cmp_eq_u32 s62, 0
    s_cbranch_scc1 L_body0
    s_cmp_eq_u32 s62, 4
    s_cbranch_scc1 L_body4
L_body2:
    s_cmp_lt_u32 s22, s23
    s_cbranch_scc0 L_bodyv2
    s_mov_b32 m0, s54
    s_waitcnt vmcnt(21)
    buffer_load_dwordx4 v56, s[28:31], s46 offen offset:0 nt lds
    s_waitcnt vmcnt(21)
    buffer_load_dwordx4 v57, s[28:31], s46 offen offset:1024 nt lds
    s_waitcnt vmcnt(21)
    buffer_load_dwordx4 v58, s[28:31], s46 offen offset:2048 nt lds
    s_waitcnt vmcnt(21)
    buffer_load_dwordx4 v59, s[28:31], s46 offen offset:3072 nt lds
    s_add_u32 m0, s54, 4096
    s_waitcnt vmcnt(21)
    buffer_load_dwordx4 v60, s[28:31], s47 offen offset:0 nt lds
    v_mov_b32 v48, s66
    s_waitcnt vmcnt(21)
    buffer_load_dwordx4 v61, s[28:31], s47 offen offset:1024 nt lds
    ds_write_b32 v6, v48
    s_add_u32 s59, s59, s56
    s_mov_b32 s67, s66
    s_mov_b32 s66, s65
    s_mov_b32 s65, s64
    s_mov_b32 s64, s59
    s_waitcnt vmcnt(21)
    buffer_load_dwordx4 v62, s[28:31], s47 offen offset:2048 nt lds
    s_waitcnt vmcnt(21)
    buffer_load_dwordx4 v63, s[28:31], s47 offen offset:3072 nt lds
    s_cmp_eq_u32 s22, 0
    s_cbranch_scc1 L_next
L_bodyv2:
    s_lshl_b32 s56, s56, 8
    s_mov_b32 m0, s55
    s_waitcnt vmcnt(21)
    buffer_load_dwordx4 v64, s[32:35], s48 offen offset:0 nt lds
    s_waitcnt vmcnt(21)
    buffer_load_dwordx4 v65, s[32:35], s48 offen offset:1024 nt lds
    ds_read_b128 v[52:55], v6 offset:16
    s_waitcnt vmcnt(21)
    buffer_load_dwordx4 v66, s[32:35], s48 offen offset:2048 nt lds
    s_waitcnt vmcnt(21)
    buffer_load_dwordx4 v67, s[32:35], s48 offen offset:3072 nt lds
    s_add_u32 m0, s55, 4096
    s_waitcnt vmcnt(21)
    buffer_load_dwordx4 v68, s[32:35], s49 offen offset:0 nt lds
    v_mov_b32 v48, s66
    s_waitcnt vmcnt(21)
    buffer_load_dwordx4 v69, s[32:35], s49 offen offset:1024 nt lds
    ds_write_b32 v6, v48
    s_add_u32 s59, s59, s56
    s_mov_b32 s67, s66
    s_mov_b32 s66, s65
    s_mov_b32 s65, s64
    s_mov_b32 s64, s59
    s_waitcnt vmcnt(21)
    buffer_load_dwordx4 v70, s[32:35], s49 offen offset:2048 nt lds
    s_waitcnt vmcnt(21)
    buffer_load_dwordx4 v71, s[32:35], s49 offen offset:3072 nt lds
L_foot:
    s_waitcnt lgkmcnt(0)
    v_readfirstlane_b32 s60, v52
    v_readfirstlane_b32 s61, v53
    v_readfirstlane_b32 s62, v54
L_next:
    s_sub_u32 s58, s58, 1
    s_cmp_gt_i32 s58, 0
    s_cbranch_scc1 L_step
    v_mov_b32 v48, s67
    s_waitcnt vmcnt(24)
    ds_write_b32 v6, v48
    v_mov_b32 v49, s66
    s_waitcnt vmcnt(16)
    ds_write_b32 v6, v49
    v_mov_b32 v48, s65
    s_waitcnt vmcnt(8)
    ds_write_b32 v6, v48
    v_mov_b32 v49, s64
    s_waitcnt vmcnt(0)
    ds_write_b32 v6, v49
    s_waitcnt lgkmcnt(0)
    s_endpgm
L_body1:
    s_cmp_lt_u32 s22, s23
    s_cbranch_scc0 L_bodyv1
    s_mov_b32 m0, s54
    s_waitcnt vmcnt(20)
    buffer_load_dwordx4 v56, s[28:31], s46 offen offset:0 nt lds
    s_waitcnt vmcnt(20)
    buffer_load_dwordx4 v57, s[28:31], s46 offen offset:1024 nt lds
    s_waitcnt vmcnt(20)
    buffer_load_dwordx4 v58, s[28:31], s46 offen offset:2048 nt lds
    s_waitcnt vmcnt(20)
    buffer_load_dwordx4 v59, s[28:31], s46 offen offset:3072 nt lds
    s_add_u32 m0, s54, 4096
    v_mov_b32 v48, s66
    s_waitcnt vmcnt(20)
    buffer_load_dwordx4 v60, s[28:31], s47 offen offset:0 nt lds
    ds_write_b32 v6, v48
    s_add_u32 s59, s59, s56
    s_mov_b32 s67, s66
    s_mov_b32 s66, s65
    s_mov_b32 s65, s64
    s_mov_b32 s64, s59
    s_waitcnt vmcnt(20)
    buffer_load_dwordx4 v61, s[28:31], s47 offen offset:1024 nt lds
    s_waitcnt vmcnt(20)
    buffer_load_dwordx4 v62, s[28:31], s47 offen offset:2048 nt lds
    s_waitcnt vmcnt(20)
    buffer_load_dwordx4 v63, s[28:31], s47 offen offset:3072 nt lds
    s_cmp_eq_u32 s22, 0
    s_cbranch_scc1 L_next
L_bodyv1:
    s_lshl_b32 s56, s56, 8
    s_mov_b32 m0, s55
    s_waitcnt vmcnt(20)
    buffer_load_dwordx4 v64, s[32:35], s48 offen offset:0 nt lds
    s_waitcnt vmcnt(20)
    buffer_load_dwordx4 v65, s[32:35], s48 offen offset:1024 nt lds
    ds_read_b128 v[52:55], v6 offset:16
    s_waitcnt vmcnt(20)
    buffer_load_dwordx4 v66, s[32:35], s48 offen offset:2048 nt lds
    s_waitcnt vmcnt(20)
    buffer_load_dwordx4 v67, s[32:35], s48 offen offset:3072 nt lds
    s_add_u32 m0, s55, 4096
    v_mov_b32 v48, s66
    s_waitcnt vmcnt(20)
    buffer_load_dwordx4 v68, s[32:35], s49 offen offset:0 nt lds
    ds_write_b32 v6, v48
    s_add_u32 s59, s59, s56
    s_mov_b32 s67, s66
    s_mov_b32 s66, s65
    s_mov_b32 s65, s64
    s_mov_b32 s64, s59
    s_waitcnt vmcnt(20)
    buffer_load_dwordx4 v69, s[32:35], s49 offen offset:1024 nt lds
    s_waitcnt vmcnt(20)
    buffer_load_dwordx4 v70, s[32:35], s49 offen offset:2048 nt lds
    s_waitcnt vmcnt(20)
    buffer_load_dwordx4 v71, s[32:35], s49 offen offset:3072 nt lds
    s_branch L_foot
L_body3:
    s_cmp_lt_u32 s22, s23
    s_cbranch_scc0 L_bodyv3
    s_mov_b32 m0, s54
    s_waitcnt vmcnt(22)
    buffer_load_dwordx4 v56, s[28:31], s46 offen offset:0 nt lds
    s_waitcnt vmcnt(22)
    buffer_load_dwordx4 v57, s[28:31], s46 offen offset:1024 nt lds
    s_waitcnt vmcnt(22)
    buffer_load_dwordx4 v58, s[28:31], s46 offen offset:2048 nt lds
    s_waitcnt vmcnt(22)
    buffer_load_dwordx4 v59, s[28:31], s46 offen offset:3072 nt lds
    s_add_u32 m0, s54, 4096
    s_waitcnt vmcnt(22)
    buffer_load_dwordx4 v60, s[28:31], s47 offen offset:0 nt lds
    s_waitcnt vmcnt(22)
    buffer_load_dwordx4 v61, s[28:31], s47 offen offset:1024 nt lds
    v_mov_b32 v48, s66
    s_waitcnt vmcnt(22)
    buffer_load_dwordx4 v62, s[28:31], s47 offen offset:2048 nt lds
    ds_write_b32 v6, v48
    s_add_u32 s59, s59, s56
    s_mov_b32 s67, s66
    s_mov_b32 s66, s65
    s_mov_b32 s65, s64
    s_mov_b32 s64, s59
    s_waitcnt vmcnt(22)
    buffer_load_dwordx4 v63, s[28:31], s47 offen offset:3072 nt lds
    s_cmp_eq_u32 s22, 0
    s_cbranch_scc1 L_next
L_bodyv3:
    s_lshl_b32 s56, s56, 8
    s_mov_b32 m0, s55
    s_waitcnt vmcnt(22)
    buffer_load_dwordx4 v64, s[32:35], s48 offen offset:0 nt lds
    s_waitcnt vmcnt(22)
    buffer_load_dwordx4 v65, s[32:35], s48 offen offset:1024 nt lds
    ds_read_b128 v[52:55], v6 offset:16
    s_waitcnt vmcnt(22)
    buffer_load_dwordx4 v66, s[32:35], s48 offen offset:2048 nt lds
    s_waitcnt vmcnt(22)
    buffer_load_dwordx4 v67, s[32:35], s48 offen offset:3072 nt lds
    s_add_u32 m0, s55, 4096
    s_waitcnt vmcnt(22)
    buffer_load_dwordx4 v68, s[32:35], s49 offen offset:0 nt lds
    s_waitcnt vmcnt(22)
    buffer_load_dwordx4 v69, s[32:35], s49 offen offset:1024 nt lds
    v_mov_b32 v48, s66
    s_waitcnt vmcnt(22)
    buffer_load_dwordx4 v70, s[32:35], s49 offen offset:2048 nt lds
    ds_write_b32 v6, v48
    s_add_u32 s59, s59, s56
    s_mov_b32 s67, s66
    s_mov_b32 s66, s65
    s_mov_b32 s65, s64
    s_mov_b32 s64, s59
    s_waitcnt vmcnt(22)
    buffer_load_dwordx4 v71, s[32:35], s49 offen offset:3072 nt lds
    s_branch L_foot
L_body0:
    s_cmp_lt_u32 s22, s23
    s_cbranch_scc0 L_bodyv0
    s_mov_b32 m0, s54
    s_waitcnt vmcnt(19)
    buffer_load_dwordx4 v56, s[28:31], s46 offen offset:0 nt lds
    s_waitcnt vmcnt(19)
    buffer_load_dwordx4 v57, s[28:31], s46 offen offset:1024 nt lds
    s_waitcnt vmcnt(19)
    buffer_load_dwordx4 v58, s[28:31], s46 offen offset:2048 nt lds
    v_mov_b32 v48, s66
    s_waitcnt vmcnt(19)
    buffer_load_dwordx4 v59, s[28:31], s46 offen offset:3072 nt lds
    ds_write_b32 v6, v48
    s_add_u32 s59, s59, s56
    s_mov_b32 s67, s66
    s_mov_b32 s66, s65
    s_mov_b32 s65, s64
    s_mov_b32 s64, s59
    s_add_u32 m0, s54, 4096
    s_waitcnt vmcnt(19)
    buffer_load_dwordx4 v60, s[28:31], s47 offen offset:0 nt lds
    s_waitcnt vmcnt(19)
    buffer_load_dwordx4 v61, s[28:31], s47 offen offset:1024 nt lds
    s_waitcnt vmcnt(19)
    buffer_load_dwordx4 v62, s[28:31], s47 offen offset:2048 nt lds
    s_waitcnt vmcnt(19)
    buffer_load_dwordx4 v63, s[28:31], s47 offen offset:3072 nt lds
    s_cmp_eq_u32 s22, 0
    s_cbranch_scc1 L_next
L_bodyv0:
    s_lshl_b32 s56, s56, 8
    s_mov_b32 m0, s55
    s_waitcnt vmcnt(19)
    buffer_load_dwordx4 v64, s[32:35], s48 offen offset:0 nt lds
    s_waitcnt vmcnt(19)
    buffer_load_dwordx4 v65, s[32:35], s48 offen offset:1024 nt lds
    ds_read_b128 v[52:55], v6 offset:16
    s_waitcnt vmcnt(19)
    buffer_load_dwordx4 v66, s[32:35], s48 offen offset:2048 nt lds
    v_mov_b32 v48, s66
    s_waitcnt vmcnt(19)
    buffer_load_dwordx4 v67, s[32:35], s48 offen offset:3072 nt lds
    ds_write_b32 v6, v48
    s_add_u32 s59, s59, s56
    s_mov_b32 s67, s66
    s_mov_b32 s66, s65
    s_mov_b32 s65, s64
    s_mov_b32 s64, s59
    s_add_u32 m0, s55, 4096
    s_waitcnt vmcnt(19)
    buffer_load_dwordx4 v68, s[32:35], s49 offen offset:0 nt lds
    s_waitcnt vmcnt(19)
    buffer_load_dwordx4 v69, s[32:35], s49 offen offset:1024 nt lds
    s_waitcnt vmcnt(19)
    buffer_load_dwordx4 v70, s[32:35], s49 offen offset:2048 nt lds
    s_waitcnt vmcnt(19)
    buffer_load_dwordx4 v71, s[32:35], s49 offen offset:3072 nt lds
    s_branch L_foot
L_body4:
    s_cmp_lt_u32 s22, s23
    s_cbranch_scc0 L_bodyv4
    s_mov_b32 m0, s54
    v_mov_b32 v48, s67
    s_waitcnt vmcnt(24)
    buffer_load_dwordx4 v56, s[28:31], s46 offen offset:0 nt lds
    ds_write_b32 v6, v48
    s_add_u32 s59, s59, s56
    s_mov_b32 s67, s66
    s_mov_b32 s66, s65
    s_mov_b32 s65, s64
    s_mov_b32 s64, s59
    s_waitcnt vmcnt(24)
    buffer_load_dwordx4 v57, s[28:31], s46 offen offset:1024 nt lds
    s_waitcnt vmcnt(24)
    buffer_load_dwordx4 v58, s[28:31], s46 offen offset:2048 nt lds
    s_waitcnt vmcnt(24)
    buffer_load_dwordx4 v59, s[28:31], s46 offen offset:3072 nt lds
    s_add_u32 m0, s54, 4096
    s_waitcnt vmcnt(24)
    buffer_load_dwordx4 v60, s[28:31], s47 offen offset:0 nt lds
    s_waitcnt vmcnt(24)
    buffer_load_dwordx4 v61, s[28:31], s47 offen offset:1024 nt lds
    s_waitcnt vmcnt(24)
    buffer_load_dwordx4 v62, s[28:31], s47 offen offset:2048 nt lds
    s_waitcnt vmcnt(24)
    buffer_load_dwordx4 v63, s[28:31], s47 offen offset:3072 nt lds
    s_cmp_eq_u32 s22, 0
    s_cbranch_scc1 L_next
L_bodyv4:
    s_lshl_b32 s56, s56, 8
    s_mov_b32 m0, s55
    v_mov_b32 v48, s67
    s_waitcnt vmcnt(24)
    buffer_load_dwordx4 v64, s[32:35], s48 offen offset:0 nt lds
    ds_write_b32 v6, v48
    s_add_u32 s59, s59, s56
    s_mov_b32 s67, s66
    s_mov_b32 s66, s65
    s_mov_b32 s65, s64
    s_mov_b32 s64, s59
    s_waitcnt vmcnt(24)
    buffer_load_dwordx4 v65, s[32:35], s48 offen offset:1024 nt lds
    ds_read_b128 v[52:55], v6 offset:16
    s_waitcnt vmcnt(24)
    buffer_load_dwordx4 v66, s[32:35], s48 offen offset:2048 nt lds
    s_waitcnt vmcnt(24)
    buffer_load_dwordx4 v67, s[32:35], s48 offen offset:3072 nt lds
    s_add_u32 m0, s55, 4096
    s_waitcnt vmcnt(24)
    buffer_load_dwordx4 v68, s[32:35], s49 offen offset:0 nt lds
    s_waitcnt vmcnt(24)
    buffer_load_dwordx4 v69, s[32:35], s49 offen offset:1024 nt lds
    s_waitcnt vmcnt(24)
    buffer_load_dwordx4 v70, s[32:35], s49 offen offset:2048 nt lds
    s_waitcnt vmcnt(24)
    buffer_load_dwordx4 v71, s[32:35], s49 offen offset:3072 nt lds
    s_branch L_foot
L_fix:
    s_mov_b64 s[74:75], s[72:73]
    s_sub_u32 s63, s72, 0
    v_sub_u32 v32, s63, v8
    v_and_or_b32 v56, v32, s68, v24
    s_sub_u32 s63, s73, 0
    v_sub_u32 v32, s63, v8
    v_and_or_b32 v64, v32, s68, v28
    s_sub_u32 s63, s72, 4
    v_sub_u32 v32, s63, v8
    v_and_or_b32 v57, v32, s68, v25
    s_sub_u32 s63, s73, 4
    v_sub_u32 v32, s63, v8
    v_and_or_b32 v65, v32, s68, v29
    s_sub_u32 s63, s72, 8
    v_sub_u32 v32, s63, v8
    v_and_or_b32 v58, v32, s68, v26
    s_sub_u32 s63, s73, 8
    v_sub_u32 v32, s63, v8
    v_and_or_b32 v66, v32, s68, v30
    s_sub_u32 s63, s72, 12
    v_sub_u32 v32, s63, v8
    v_and_or_b32 v59, v32, s68, v27
    s_sub_u32 s63, s73, 12
    v_sub_u32 v32, s63, v8
    v_and_or_b32 v67, v32, s68, v31
    s_sub_u32 s63, s72, 16
    v_sub_u32 v32, s63, v8
    v_and_or_b32 v60, v32, s68, v24
    s_sub_u32 s63, s73, 16
    v_sub_u32 v32, s63, v8
    v_and_or_b32 v68, v32, s68, v28
    s_sub_u32 s63, s72, 20
    v_sub_u32 v32, s63, v8
    v_and_or_b32 v61, v32, s68, v25
    s_sub_u32 s63, s73, 20
    v_sub_u32 v32, s63, v8
    v_and_or_b32 v69, v32, s68, v29
    s_sub_u32 s63, s72, 24
    v_sub_u32 v32, s63, v8
    v_and_or_b32 v62, v32, s68, v26
    s_sub_u32 s63, s73, 24
    v_sub_u32 v32, s63, v8
    v_and_or_b32 v70, v32, s68, v30
    s_sub_u32 s63, s72, 28
    v_sub_u32 v32, s63, v8
    v_and_or_b32 v63, v32, s68, v27
    s_sub_u32 s63, s73, 28
    v_sub_u32 v32, s63, v8
    v_and_or_b32 v71, v32, s68, v31
    s_branch L_fixed
L_spin:
    s_mov_b32 s69, 2097152
L_spin1:
    ds_read_b128 v[52:55], v6 offset:16
    s_sub_u32 s69, s69, 1
    s_cbranch_scc1 L_end
    s_waitcnt lgkmcnt(0)
    v_readfirstlane_b32 s60, v52
    v_readfirstlane_b32 s61, v53
    s_cmp_eq_u32 s56, 1
    s_cselect_b32 s24, s60, s61
    s_cmp_ge_i32 s24, s63
    s_cbranch_scc0 L_spin1
    s_branch L_go
L_cons2:
    s_lshr_b32 s44, s3, 4
    s_add_u32 s44, s44, 131084
    v_mov_b32 v237, s44
    v_mov_b32 v5, 0
    ds_write_b32 v237, v5
    v_and_b32 v0, 63, v0
    v_and_b32 v1, 31, v0
    v_lshrrev_b32 v2, 5, v0
    v_lshlrev_b32 v3, 8, v1
    v_lshl_add_u32 v4, v2, 4, v3
    s_waitcnt lgkmcnt(0)
    s_barrier
    s_lshl_b32 s37, s36, 2
    s_load_dword s46, s[12:13], s37
    s_add_u32 s32, s14, s45
    s_addc_u32 s33, s15, 0
    s_and_b32 s33, s33, 0xffff
    s_movk_i32 s34, 0x2000
    s_mov_b32 s35, 0x20000
    s_lshr_b32 s44, s3, 7
    s_lshl_b32 s44, s44, 16
    v_and_b32 v7, 15, v0
    v_xor_b32 v5, v2, v7
    v_lshl_add_u32 v5, v5, 4, v3
    v_add_u32 v224, s44, v5
    v_xor_b32 v225, 32, v224
    v_xor_b32 v226, 64, v224
    v_xor_b32 v227, 96, v224
    v_xor_b32 v228, 128, v224
    v_xor_b32 v229, 160, v224
    v_xor_b32 v230, 192, v224
    v_xor_b32 v231, 224, v224
    v_bfe_u32 v5, v0, 2, 2
    v_lshl_add_u32 v9, v2, 2, v5
    v_lshlrev_b32 v9, 8, v9
    v_lshl_add_u32 v9, v5, 6, v9
    v_bfe_u32 v8, v0, 4, 1
    v_lshl_add_u32 v9, v8, 5, v9
    v_and_b32 v8, 3, v0
    v_lshl_add_u32 v9, v8, 3, v9
    s_add_u32 s45, s44, 8192
    v_add_u32 v232, s45, v9
    v_xor_b32 v233, 64, v232
    v_xor_b32 v234, 128, v232
    v_xor_b32 v235, 192, v232
    s_lshr_b32 s45, s3, 5
    s_add_u32 s45, s45, 131070
    v_mov_b32 v236, s45
    v_lshlrev_b32 v239, 2, v2
    v_mov_b32 v238, v4
    v_and_b32 v5, 7, v0
    v_lshlrev_b32 v8, 7, v1
    v_lshl_add_u32 v8, v5, 4, v8
    v_lshl_add_u32 v8, v2, 3, v8
    v_add_u32 v200, s44, v8
    v_xor_b32 v201, 16, v200
    v_xor_b32 v202, 32, v200
    v_xor_b32 v203, 48, v200
    v_xor_b32 v204, 64, v200
    v_xor_b32 v205, 80, v200
    v_xor_b32 v206, 96, v200
    v_xor_b32 v207, 112, v200
    v_lshrrev_b32 v8, 3, v0
    v_xor_b32 v9, v5, v8
    v_lshlrev_b32 v9, 4, v9
    v_lshl_add_u32 v9, v8, 7, v9
    v_add_u32 v240, s44, v9
    v_lshlrev_b32 v9, 4, v5
    v_lshl_add_u32 v238, v8, 8, v9
    s_movk_i32 s51, 0x1000
    s_mov_b32 s43, 0x3e0293ee
    v_mov_b32 v14, 0xff800000
    v_mov_b32 v10, 0
    v_mov_b32 v11, 0
    v_mov_b32 v1, 1
    v_mov_b32 v128, 0
    v_mov_b32 v129, 0
    v_mov_b32 v130, 0
    v_mov_b32 v131, 0
    v_mov_b32 v132, 0
    v_mov_b32 v133, 0
    v_mov_b32 v134, 0
    v_mov_b32 v135, 0
    v_mov_b32 v136, 0
    v_mov_b32 v137, 0
    v_mov_b32 v138, 0
    v_mov_b32 v139, 0
    v_mov_b32 v140, 0
    v_mov_b32 v141, 0
    v_mov_b32 v142, 0
    v_mov_b32 v143, 0
    v_mov_b32 v144, 0
    v_mov_b32 v145, 0
    v_mov_b32 v146, 0
    v_mov_b32 v147, 0
    v_mov_b32 v148, 0
    v_mov_b32 v149, 0
    v_mov_b32 v150, 0
    v_mov_b32 v151, 0
    v_mov_b32 v152, 0
    v_mov_b32 v153, 0
    v_mov_b32 v154, 0
    v_mov_b32 v155, 0
    v_mov_b32 v156, 0
    v_mov_b32 v157, 0
    v_mov_b32 v158, 0
    v_mov_b32 v159, 0
    v_mov_b32 v160, 0
    v_mov_b32 v161, 0
    v_mov_b32 v162, 0
    v_mov_b32 v163, 0
    v_mov_b32 v164, 0
    v_mov_b32 v165, 0
    v_mov_b32 v166, 0
    v_mov_b32 v167, 0
    v_mov_b32 v168, 0
    v_mov_b32 v169, 0
    v_mov_b32 v170, 0
    v_mov_b32 v171, 0
    v_mov_b32 v172, 0
    v_mov_b32 v173, 0
    v_mov_b32 v174, 0
    v_mov_b32 v175, 0
    v_mov_b32 v176, 0
    v_mov_b32 v177, 0
    v_mov_b32 v178, 0
    v_mov_b32 v179, 0
    v_mov_b32 v180, 0
    v_mov_b32 v181, 0
    v_mov_b32 v182, 0
    v_mov_b32 v183, 0
    v_mov_b32 v184, 0
    v_mov_b32 v185, 0
    v_mov_b32 v186, 0
    v_mov_b32 v187, 0
    v_mov_b32 v188, 0
    v_mov_b32 v189, 0
    v_mov_b32 v190, 0
    v_mov_b32 v191, 0
    s_mov_b32 s39, 0
    s_movk_i32 s44, 0x4000
    s_movk_i32 s48, 0x4000
    s_waitcnt lgkmcnt(0)
    s_sub_u32 s37, s46, 1
    s_min_u32 s37, s37, 0x7ff
    s_lshr_b32 s38, s37, 5
    s_and_b32 s47, s37, 31
    s_xor_b32 s49, s20, 16
    s_lshr_b32 s49, s49, 1
    s_cmpk_eq_u32 s3, 64
    s_cselect_b32 s49, s20, s49
    s_add_u32 s49, s49, 2
    s_min_u32 s49, s49, s38
    s_sub_u32 s49, s49, 1
    s_sub_i32 s45, s47, 0
    v_cmp_lt_i32 vcc, s45, v239
    s_nop 1
    v_cndmask_b32 v208, 0, v14, vcc
    s_sub_i32 s45, s47, 1
    v_cmp_lt_i32 vcc, s45, v239
    s_nop 1
    v_cndmask_b32 v209, 0, v14, vcc
    s_sub_i32 s45, s47, 2
    v_cmp_lt_i32 vcc, s45, v239
    s_nop 1
    v_cndmask_b32 v210, 0, v14, vcc
    s_sub_i32 s45, s47, 3
    v_cmp_lt_i32 vcc, s45, v239
    s_nop 1
    v_cndmask_b32 v211, 0, v14, vcc
    s_sub_i32 s45, s47, 8
    v_cmp_lt_i32 vcc, s45, v239
    s_nop 1
    v_cndmask_b32 v212, 0, v14, vcc
    s_sub_i32 s45, s47, 9
    v_cmp_lt_i32 vcc, s45, v239
    s_nop 1
    v_cndmask_b32 v213, 0, v14, vcc
    s_sub_i32 s45, s47, 10
    v_cmp_lt_i32 vcc, s45, v239
    s_nop 1
    v_cndmask_b32 v214, 0, v14, vcc
    s_sub_i32 s45, s47, 11
    v_cmp_lt_i32 vcc, s45, v239
    s_nop 1
    v_cndmask_b32 v215, 0, v14, vcc
    s_sub_i32 s45, s47, 16
    v_cmp_lt_i32 vcc, s45, v239
    s_nop 1
    v_cndmask_b32 v216, 0, v14, vcc
    s_sub_i32 s45, s47, 17
    v_cmp_lt_i32 vcc, s45, v239
    s_nop 1
    v_cndmask_b32 v217, 0, v14, vcc
    s_sub_i32 s45, s47, 18
    v_cmp_lt_i32 vcc, s45, v239
    s_nop 1
    v_cndmask_b32 v218, 0, v14, vcc
    s_sub_i32 s45, s47, 19
    v_cmp_lt_i32 vcc, s45, v239
    s_nop 1
    v_cndmask_b32 v219, 0, v14, vcc
    s_sub_i32 s45, s47, 24
    v_cmp_lt_i32 vcc, s45, v239
    s_nop 1
    v_cndmask_b32 v220, 0, v14, vcc
    s_sub_i32 s45, s47, 25
    v_cmp_lt_i32 vcc, s45, v239
    s_nop 1
    v_cndmask_b32 v221, 0, v14, vcc
    s_sub_i32 s45, s47, 26
    v_cmp_lt_i32 vcc, s45, v239
    s_nop 1
    v_cndmask_b32 v222, 0, v14, vcc
    s_sub_i32 s45, s47, 27
    v_cmp_lt_i32 vcc, s45, v239
    s_nop 1
    v_cndmask_b32 v223, 0, v14, vcc
    s_waitcnt vmcnt(0)
    ds_read_b128 v[16:19], v224 offset:0xe000
    ds_read_b128 v[20:23], v225 offset:0xe000
    ds_read_b128 v[24:27], v226 offset:0xe000
    ds_read_b128 v[28:31], v227 offset:0xe000
    ds_read_b128 v[32:35], v228 offset:0xe000
    ds_read_b128 v[36:39], v229 offset:0xe000
    ds_read_b128 v[40:43], v230 offset:0xe000
    ds_read_b128 v[44:47], v231 offset:0xe000
    s_waitcnt lgkmcnt(0)
    s_cmp_gt_i32 s46, 0
    s_cbranch_scc0 L_zeroq
L_first:
    s_mov_b32 s42, 2097152
L_pollK:
    ds_read_u8 v15, v236 offset:0
    s_sub_u32 s42, s42, 1
    s_cbranch_scc1 L_end
L_pwK:
    s_waitcnt lgkmcnt(0)
    v_readfirstlane_b32 s41, v15
    s_cmp_gt_u32 s41, s39
    s_cbranch_scc0 L_pollK
    ds_read_b128 v[64:67], v224
    ds_read_b128 v[68:71], v225
    ds_read_b128 v[72:75], v226
    ds_read_b128 v[76:79], v227
    ds_read_b128 v[80:83], v228
    ds_read_b128 v[84:87], v229
    ds_read_b128 v[88:91], v230
    ds_read_b128 v[92:95], v231
    s_cmp_eq_u32 s38, 0
    s_waitcnt lgkmcnt(7)
    s_cbranch_scc1 L_qkbA
    v_mfma_f32_32x32x16_bf16 v[48:63], v[64:67], v[16:19], 0
L_qkrA:
    s_waitcnt lgkmcnt(6)
    v_mfma_f32_32x32x16_bf16 v[48:63], v[68:71], v[20:23], v[48:63]
    s_waitcnt lgkmcnt(5)
    v_mfma_f32_32x32x16_bf16 v[48:63], v[72:75], v[24:27], v[48:63]
    s_waitcnt lgkmcnt(4)
    v_mfma_f32_32x32x16_bf16 v[48:63], v[76:79], v[28:31], v[48:63]
    s_waitcnt lgkmcnt(3)
    v_mfma_f32_32x32x16_bf16 v[48:63], v[80:83], v[32:35], v[48:63]
    s_waitcnt lgkmcnt(2)
    v_mfma_f32_32x32x16_bf16 v[48:63], v[84:87], v[36:39], v[48:63]
    s_waitcnt lgkmcnt(1)
    v_mfma_f32_32x32x16_bf16 v[48:63], v[88:91], v[40:43], v[48:63]
    s_waitcnt lgkmcnt(0)
    v_mfma_f32_32x32x16_bf16 v[48:63], v[92:95], v[44:47], v[48:63]
    ds_write_b32 v237, v1
    s_cselect_b32 s45, 1, 0
    v_add_u32 v0, s45, v236
    ds_read_u8 v15, v0
    v_xor_b32 v224, s44, v224
    v_xor_b32 v225, s44, v225
    v_xor_b32 v226, s44, v226
    v_xor_b32 v227, s44, v227
    v_xor_b32 v228, s44, v228
    v_xor_b32 v229, s44, v229
    v_xor_b32 v230, s44, v230
    v_xor_b32 v231, s44, v231
    s_xor_b32 s44, s44, 0x8000
    s_nop 0
    v_max3_f32 v2, v48, v49, v50
    v_max3_f32 v3, v51, v52, v53
    v_max3_f32 v4, v54, v55, v56
    v_max3_f32 v5, v57, v58, v59
    v_max3_f32 v6, v60, v61, v62
    v_max3_f32 v2, v2, v3, v63
    v_max3_f32 v4, v4, v5, v6
    v_max3_f32 v2, v2, v4, v14
    v_mov_b32 v3, v2
    s_nop 1
    v_permlane32_swap_b32 v2, v3
    v_max_f32 v2, v2, v3
    v_sub_f32 v3, v14, v2
    v_mul_f32 v13, s43, v2
    v_mul_f32 v3, s43, v3
    v_mov_b32 v14, v2
    v_exp_f32 v12, v3
    v_fma_f32 v48, v48, s43, -v13
    v_fma_f32 v49, v49, s43, -v13
    v_fma_f32 v50, v50, s43, -v13
    v_fma_f32 v51, v51, s43, -v13
    v_fma_f32 v52, v52, s43, -v13
    v_fma_f32 v53, v53, s43, -v13
    v_fma_f32 v54, v54, s43, -v13
    v_fma_f32 v55, v55, s43, -v13
    v_fma_f32 v56, v56, s43, -v13
    v_fma_f32 v57, v57, s43, -v13
    v_fma_f32 v58, v58, s43, -v13
    v_fma_f32 v59, v59, s43, -v13
    v_fma_f32 v60, v60, s43, -v13
    v_fma_f32 v61, v61, s43, -v13
    v_fma_f32 v62, v62, s43, -v13
    v_fma_f32 v63, v63, s43, -v13
    v_exp_f32 v48, v48
    v_exp_f32 v49, v49
    v_exp_f32 v50, v50
    v_exp_f32 v51, v51
    v_cvt_pk_bf16_f32 v192, v48, v49
    v_exp_f32 v52, v52
    v_pk_add_f32 v[2:3], v[48:49], v[50:51]
    v_exp_f32 v53, v53
    v_cvt_pk_bf16_f32 v193, v50, v51
    v_exp_f32 v54, v54
    v_exp_f32 v55, v55
    v_cvt_pk_bf16_f32 v194, v52, v53
    v_exp_f32 v56, v56
    v_pk_add_f32 v[4:5], v[52:53], v[54:55]
    v_exp_f32 v57, v57
    v_cvt_pk_bf16_f32 v195, v54, v55
    v_exp_f32 v58, v58
    v_exp_f32 v59, v59
    v_cvt_pk_bf16_f32 v196, v56, v57
    v_exp_f32 v60, v60
    v_pk_add_f32 v[6:7], v[56:57], v[58:59]
    v_exp_f32 v61, v61
    v_cvt_pk_bf16_f32 v197, v58, v59
    v_exp_f32 v62, v62
    v_exp_f32 v63, v63
    v_cvt_pk_bf16_f32 v198, v60, v61
    v_pk_add_f32 v[2:3], v[2:3], v[4:5]
    v_cvt_pk_bf16_f32 v199, v62, v63
    v_pk_add_f32 v[8:9], v[60:61], v[62:63]
    v_pk_fma_f32 v[10:11], v[10:11], v[12:13], v[2:3] op_sel_hi:[1,0,1]
    v_pk_add_f32 v[6:7], v[6:7], v[8:9]
    v_pk_add_f32 v[10:11], v[10:11], v[6:7]
    s_cmp_eq_u32 s38, 0
    s_cbranch_scc1 L_last
L_tile:
    s_add_u32 s50, s39, 1
    s_mov_b32 s42, 2097152
    s_branch L_pwN
L_pollN:
    ds_read_u8 v15, v236 offset:0
    s_sub_u32 s42, s42, 1
    s_cbranch_scc1 L_end
L_pwN:
    s_waitcnt lgkmcnt(0)
    v_readfirstlane_b32 s41, v15
    s_cmp_gt_u32 s41, s50
    s_cbranch_scc0 L_pollN
    ds_read_b128 v[64:67], v224
    ds_read_b128 v[68:71], v225
    ds_read_b128 v[72:75], v226
    ds_read_b128 v[76:79], v227
    ds_read_b128 v[80:83], v228
    ds_read_b128 v[84:87], v229
    ds_read_b128 v[88:91], v230
    ds_read_b128 v[92:95], v231
    s_cmp_eq_u32 s39, s49
    v_pk_mul_f32 v[128:129], v[128:129], v[12:13] op_sel_hi:[1,0]
    v_pk_mul_f32 v[130:131], v[130:131], v[12:13] op_sel_hi:[1,0]
    v_pk_mul_f32 v[132:133], v[132:133], v[12:13] op_sel_hi:[1,0]
    v_pk_mul_f32 v[134:135], v[134:135], v[12:13] op_sel_hi:[1,0]
    v_pk_mul_f32 v[136:137], v[136:137], v[12:13] op_sel_hi:[1,0]
    v_pk_mul_f32 v[138:139], v[138:139], v[12:13] op_sel_hi:[1,0]
    v_pk_mul_f32 v[140:141], v[140:141], v[12:13] op_sel_hi:[1,0]
    v_pk_mul_f32 v[142:143], v[142:143], v[12:13] op_sel_hi:[1,0]
    v_pk_mul_f32 v[144:145], v[144:145], v[12:13] op_sel_hi:[1,0]
    v_pk_mul_f32 v[146:147], v[146:147], v[12:13] op_sel_hi:[1,0]
    v_pk_mul_f32 v[148:149], v[148:149], v[12:13] op_sel_hi:[1,0]
    v_pk_mul_f32 v[150:151], v[150:151], v[12:13] op_sel_hi:[1,0]
    v_pk_mul_f32 v[152:153], v[152:153], v[12:13] op_sel_hi:[1,0]
    v_pk_mul_f32 v[154:155], v[154:155], v[12:13] op_sel_hi:[1,0]
    v_pk_mul_f32 v[156:157], v[156:157], v[12:13] op_sel_hi:[1,0]
    v_pk_mul_f32 v[158:159], v[158:159], v[12:13] op_sel_hi:[1,0]
    s_waitcnt lgkmcnt(7)
    s_cbranch_scc1 L_qkbB
    v_mfma_f32_32x32x16_bf16 v[48:63], v[64:67], v[16:19], 0
L_qkrB:
    v_mul_f32 v160, v12, v160
    v_mul_f32 v161, v12, v161
    v_mul_f32 v162, v12, v162
    v_mul_f32 v163, v12, v163
    v_xor_b32 v224, s44, v224
    s_waitcnt lgkmcnt(6)
    v_mfma_f32_32x32x16_bf16 v[48:63], v[68:71], v[20:23], v[48:63]
    v_mul_f32 v164, v12, v164
    v_mul_f32 v165, v12, v165
    v_mul_f32 v166, v12, v166
    v_mul_f32 v167, v12, v167
    v_xor_b32 v225, s44, v225
    s_waitcnt lgkmcnt(5)
    v_mfma_f32_32x32x16_bf16 v[48:63], v[72:75], v[24:27], v[48:63]
    v_mul_f32 v168, v12, v168
    v_mul_f32 v169, v12, v169
    v_mul_f32 v170, v12, v170
    v_mul_f32 v171, v12, v171
    v_xor_b32 v226, s44, v226
    s_waitcnt lgkmcnt(4)
    v_mfma_f32_32x32x16_bf16 v[48:63], v[76:79], v[28:31], v[48:63]
    v_mul_f32 v172, v12, v172
    v_mul_f32 v173, v12, v173
    v_mul_f32 v174, v12, v174
    v_mul_f32 v175, v12, v175
    v_xor_b32 v227, s44, v227
    s_waitcnt lgkmcnt(3)
    v_mfma_f32_32x32x16_bf16 v[48:63], v[80:83], v[32:35], v[48:63]
    v_mul_f32 v176, v12, v176
    v_mul_f32 v177, v12, v177
    v_mul_f32 v178, v12, v178
    v_mul_f32 v179, v12, v179
    v_xor_b32 v228, s44, v228
    s_waitcnt lgkmcnt(2)
    v_mfma_f32_32x32x16_bf16 v[48:63], v[84:87], v[36:39], v[48:63]
    v_mul_f32 v180, v12, v180
    v_mul_f32 v181, v12, v181
    v_mul_f32 v182, v12, v182
    v_mul_f32 v183, v12, v183
    v_xor_b32 v229, s44, v229
    s_waitcnt lgkmcnt(1)
    v_mfma_f32_32x32x16_bf16 v[48:63], v[88:91], v[40:43], v[48:63]
    v_mul_f32 v184, v12, v184
    v_mul_f32 v185, v12, v185
    v_mul_f32 v186, v12, v186
    v_mul_f32 v187, v12, v187
    v_xor_b32 v230, s44, v230
    s_waitcnt lgkmcnt(0)
    v_mfma_f32_32x32x16_bf16 v[48:63], v[92:95], v[44:47], v[48:63]
    ds_read_u8 v15, v236 offset:1
    v_mul_f32 v188, v12, v188
    v_mul_f32 v189, v12, v189
    v_mul_f32 v190, v12, v190
    v_mul_f32 v191, v12, v191
    v_xor_b32 v231, s44, v231
    s_mov_b32 s42, 2097152
    s_branch L_pwV
L_pollV:
    ds_read_u8 v15, v236 offset:1
    s_sub_u32 s42, s42, 1
    s_cbranch_scc1 L_end
L_pwV:
    s_waitcnt lgkmcnt(0)
    v_readfirstlane_b32 s41, v15
    s_cmp_gt_u32 s41, s39
    s_cbranch_scc0 L_pollV
    ds_read_b64_tr_b16 v[96:97], v232 offset:0
    ds_read_b64_tr_b16 v[98:99], v232 offset:2048
    ds_read_b64_tr_b16 v[100:101], v232 offset:4096
    ds_read_b64_tr_b16 v[102:103], v232 offset:6144
    ds_read_b64_tr_b16 v[104:105], v233 offset:0
    ds_read_b64_tr_b16 v[106:107], v233 offset:2048
    ds_read_b64_tr_b16 v[108:109], v233 offset:4096
    ds_read_b64_tr_b16 v[110:111], v233 offset:6144
    ds_read_b64_tr_b16 v[112:113], v234 offset:0
    ds_read_b64_tr_b16 v[114:115], v234 offset:2048
    ds_read_b64_tr_b16 v[116:117], v234 offset:4096
    ds_read_b64_tr_b16 v[118:119], v234 offset:6144
    ds_read_b64_tr_b16 v[120:121], v235 offset:0
    ds_read_b64_tr_b16 v[122:123], v235 offset:2048
    ds_read_b64_tr_b16 v[124:125], v235 offset:4096
    ds_read_b64_tr_b16 v[126:127], v235 offset:6144
    v_max3_f32 v2, v48, v49, v50
    v_max3_f32 v3, v51, v52, v53
    v_max3_f32 v4, v54, v55, v56
    v_max3_f32 v5, v57, v58, v59
    v_max3_f32 v6, v60, v61, v62
    v_max3_f32 v2, v2, v3, v63
    v_max3_f32 v4, v4, v5, v6
    v_max3_f32 v2, v2, v4, v14
    v_mov_b32 v3, v2
    v_add_u32 v1, 1, v1
    v_xor_b32 v232, s48, v232
    v_permlane32_swap_b32 v2, v3
    v_max_f32 v2, v2, v3
    v_sub_f32 v3, v14, v2
    v_mul_f32 v13, s43, v2
    v_mul_f32 v3, s43, v3
    v_mov_b32 v14, v2
    v_exp_f32 v12, v3
    v_xor_b32 v233, s48, v233
    v_xor_b32 v234, s48, v234
    v_xor_b32 v235, s48, v235
    s_waitcnt lgkmcnt(14)
    v_mfma_f32_32x32x16_bf16 v[128:143], v[96:99], v[192:195], v[128:143]
    v_fma_f32 v48, v48, s43, -v13
    v_fma_f32 v49, v49, s43, -v13
    v_fma_f32 v50, v50, s43, -v13
    v_fma_f32 v51, v51, s43, -v13
    v_fma_f32 v52, v52, s43, -v13
    v_fma_f32 v53, v53, s43, -v13
    s_waitcnt lgkmcnt(12)
    v_mfma_f32_32x32x16_bf16 v[128:143], v[100:103], v[196:199], v[128:143]
    v_fma_f32 v54, v54, s43, -v13
    v_fma_f32 v55, v55, s43, -v13
    v_fma_f32 v56, v56, s43, -v13
    v_fma_f32 v57, v57, s43, -v13
    v_fma_f32 v58, v58, s43, -v13
    v_fma_f32 v59, v59, s43, -v13
    s_waitcnt lgkmcnt(10)
    v_mfma_f32_32x32x16_bf16 v[144:159], v[104:107], v[192:195], v[144:159]
    v_fma_f32 v60, v60, s43, -v13
    v_fma_f32 v61, v61, s43, -v13
    v_fma_f32 v62, v62, s43, -v13
    v_fma_f32 v63, v63, s43, -v13
    v_exp_f32 v48, v48
    s_waitcnt lgkmcnt(8)
    v_mfma_f32_32x32x16_bf16 v[144:159], v[108:111], v[196:199], v[144:159]
    v_exp_f32 v49, v49
    v_exp_f32 v50, v50
    v_exp_f32 v51, v51
    s_waitcnt lgkmcnt(6)
    v_mfma_f32_32x32x16_bf16 v[160:175], v[112:115], v[192:195], v[160:175]
    v_exp_f32 v52, v52
    v_exp_f32 v53, v53
    v_exp_f32 v54, v54
    s_waitcnt lgkmcnt(4)
    v_mfma_f32_32x32x16_bf16 v[160:175], v[116:119], v[196:199], v[160:175]
    v_exp_f32 v55, v55
    v_exp_f32 v56, v56
    v_exp_f32 v57, v57
    s_waitcnt lgkmcnt(2)
    v_mfma_f32_32x32x16_bf16 v[176:191], v[120:123], v[192:195], v[176:191]
    v_exp_f32 v58, v58
    v_exp_f32 v59, v59
    v_exp_f32 v60, v60
    s_waitcnt lgkmcnt(0)
    v_mfma_f32_32x32x16_bf16 v[176:191], v[124:127], v[196:199], v[176:191]
    ds_write_b32 v237, v1
    s_add_u32 s39, s39, 1
    s_cmp_lt_u32 s39, s38
    s_cselect_b32 s45, 0, 1
    v_add_u32 v0, s45, v236
    ds_read_u8 v15, v0
    v_pk_add_f32 v[2:3], v[48:49], v[50:51]
    v_exp_f32 v61, v61
    v_pk_add_f32 v[4:5], v[52:53], v[54:55]
    v_exp_f32 v62, v62
    v_pk_add_f32 v[6:7], v[56:57], v[58:59]
    v_exp_f32 v63, v63
    v_pk_add_f32 v[2:3], v[2:3], v[4:5]
    s_xor_b32 s44, s44, 0x8000
    s_xor_b32 s48, s48, 0x8000
    v_pk_add_f32 v[8:9], v[60:61], v[62:63]
    v_pk_fma_f32 v[10:11], v[10:11], v[12:13], v[2:3] op_sel_hi:[1,0,1]
    v_pk_add_f32 v[6:7], v[6:7], v[8:9]
    s_cmp_lt_u32 s39, s38
    v_pk_add_f32 v[10:11], v[10:11], v[6:7]
    s_cbranch_scc0 L_last
    v_cvt_pk_bf16_f32 v192, v48, v49
    v_cvt_pk_bf16_f32 v193, v50, v51
    v_cvt_pk_bf16_f32 v194, v52, v53
    v_cvt_pk_bf16_f32 v195, v54, v55
    v_cvt_pk_bf16_f32 v196, v56, v57
    v_cvt_pk_bf16_f32 v197, v58, v59
    v_cvt_pk_bf16_f32 v198, v60, v61
    v_cvt_pk_bf16_f32 v199, v62, v63
    s_branch L_tile
L_last:
    v_add_f32 v10, v10, v11
    v_mov_b32 v2, v10
    s_nop 1
    v_permlane32_swap_b32 v10, v2
    v_add_f32 v10, v10, v2
    v_rcp_f32 v10, v10
    s_nop 0
    v_mul_f32 v12, v12, v10
    v_pk_mul_f32 v[48:49], v[48:49], v[10:11] op_sel_hi:[1,0]
    v_pk_mul_f32 v[50:51], v[50:51], v[10:11] op_sel_hi:[1,0]
    v_pk_mul_f32 v[52:53], v[52:53], v[10:11] op_sel_hi:[1,0]
    v_pk_mul_f32 v[54:55], v[54:55], v[10:11] op_sel_hi:[1,0]
    v_pk_mul_f32 v[56:57], v[56:57], v[10:11] op_sel_hi:[1,0]
    v_pk_mul_f32 v[58:59], v[58:59], v[10:11] op_sel_hi:[1,0]
    v_pk_mul_f32 v[60:61], v[60:61], v[10:11] op_sel_hi:[1,0]
    v_pk_mul_f32 v[62:63], v[62:63], v[10:11] op_sel_hi:[1,0]
    v_pk_mul_f32 v[128:129], v[128:129], v[12:13] op_sel_hi:[1,0]
    v_pk_mul_f32 v[130:131], v[130:131], v[12:13] op_sel_hi:[1,0]
    v_pk_mul_f32 v[132:133], v[132:133], v[12:13] op_sel_hi:[1,0]
    v_pk_mul_f32 v[134:135], v[134:135], v[12:13] op_sel_hi:[1,0]
    v_pk_mul_f32 v[136:137], v[136:137], v[12:13] op_sel_hi:[1,0]
    v_pk_mul_f32 v[138:139], v[138:139], v[12:13] op_sel_hi:[1,0]
    v_pk_mul_f32 v[140:141], v[140:141], v[12:13] op_sel_hi:[1,0]
    v_pk_mul_f32 v[142:143], v[142:143], v[12:13] op_sel_hi:[1,0]
    v_pk_mul_f32 v[144:145], v[144:145], v[12:13] op_sel_hi:[1,0]
    v_pk_mul_f32 v[146:147], v[146:147], v[12:13] op_sel_hi:[1,0]
    v_pk_mul_f32 v[148:149], v[148:149], v[12:13] op_sel_hi:[1,0]
    v_pk_mul_f32 v[150:151], v[150:151], v[12:13] op_sel_hi:[1,0]
    v_pk_mul_f32 v[152:153], v[152:153], v[12:13] op_sel_hi:[1,0]
    v_pk_mul_f32 v[154:155], v[154:155], v[12:13] op_sel_hi:[1,0]
    v_pk_mul_f32 v[156:157], v[156:157], v[12:13] op_sel_hi:[1,0]
    v_pk_mul_f32 v[158:159], v[158:159], v[12:13] op_sel_hi:[1,0]
    v_pk_mul_f32 v[160:161], v[160:161], v[12:13] op_sel_hi:[1,0]
    v_pk_mul_f32 v[162:163], v[162:163], v[12:13] op_sel_hi:[1,0]
    v_pk_mul_f32 v[164:165], v[164:165], v[12:13] op_sel_hi:[1,0]
    ds_read_u8 v15, v236 offset:1
    v_pk_mul_f32 v[166:167], v[166:167], v[12:13] op_sel_hi:[1,0]
    v_pk_mul_f32 v[168:169], v[168:169], v[12:13] op_sel_hi:[1,0]
    v_pk_mul_f32 v[170:171], v[170:171], v[12:13] op_sel_hi:[1,0]
    v_pk_mul_f32 v[172:173], v[172:173], v[12:13] op_sel_hi:[1,0]
    v_pk_mul_f32 v[174:175], v[174:175], v[12:13] op_sel_hi:[1,0]
    v_pk_mul_f32 v[176:177], v[176:177], v[12:13] op_sel_hi:[1,0]
    v_pk_mul_f32 v[178:179], v[178:179], v[12:13] op_sel_hi:[1,0]
    v_pk_mul_f32 v[180:181], v[180:181], v[12:13] op_sel_hi:[1,0]
    v_pk_mul_f32 v[182:183], v[182:183], v[12:13] op_sel_hi:[1,0]
    v_pk_mul_f32 v[184:185], v[184:185], v[12:13] op_sel_hi:[1,0]
    v_pk_mul_f32 v[186:187], v[186:187], v[12:13] op_sel_hi:[1,0]
    v_pk_mul_f32 v[188:189], v[188:189], v[12:13] op_sel_hi:[1,0]
    v_pk_mul_f32 v[190:191], v[190:191], v[12:13] op_sel_hi:[1,0]
    v_cvt_pk_bf16_f32 v192, v48, v49
    v_cvt_pk_bf16_f32 v193, v50, v51
    v_cvt_pk_bf16_f32 v194, v52, v53
    v_cvt_pk_bf16_f32 v195, v54, v55
    v_cvt_pk_bf16_f32 v196, v56, v57
    v_cvt_pk_bf16_f32 v197, v58, v59
    v_cvt_pk_bf16_f32 v198, v60, v61
    v_cvt_pk_bf16_f32 v199, v62, v63
    s_mov_b32 s42, 2097152
    s_branch L_pwL
L_pollL:
    ds_read_u8 v15, v236 offset:1
    s_sub_u32 s42, s42, 1
    s_cbranch_scc1 L_end
L_pwL:
    s_waitcnt lgkmcnt(0)
    v_readfirstlane_b32 s41, v15
    s_cmp_gt_u32 s41, s39
    s_cbranch_scc0 L_pollL
    ds_read_b64_tr_b16 v[96:97], v232 offset:0
    ds_read_b64_tr_b16 v[98:99], v232 offset:2048
    ds_read_b64_tr_b16 v[100:101], v232 offset:4096
    ds_read_b64_tr_b16 v[102:103], v232 offset:6144
    ds_read_b64_tr_b16 v[104:105], v233 offset:0
    ds_read_b64_tr_b16 v[106:107], v233 offset:2048
    ds_read_b64_tr_b16 v[108:109], v233 offset:4096
    ds_read_b64_tr_b16 v[110:111], v233 offset:6144
    ds_read_b64_tr_b16 v[112:113], v234 offset:0
    ds_read_b64_tr_b16 v[114:115], v234 offset:2048
    ds_read_b64_tr_b16 v[116:117], v234 offset:4096
    ds_read_b64_tr_b16 v[118:119], v234 offset:6144
    ds_read_b64_tr_b16 v[120:121], v235 offset:0
    ds_read_b64_tr_b16 v[122:123], v235 offset:2048
    ds_read_b64_tr_b16 v[124:125], v235 offset:4096
    ds_read_b64_tr_b16 v[126:127], v235 offset:6144
    s_waitcnt lgkmcnt(14)
    v_mfma_f32_32x32x16_bf16 v[128:143], v[96:99], v[192:195], v[128:143]
    s_waitcnt lgkmcnt(12)
    v_mfma_f32_32x32x16_bf16 v[128:143], v[100:103], v[196:199], v[128:143]
    s_waitcnt lgkmcnt(10)
    v_mfma_f32_32x32x16_bf16 v[144:159], v[104:107], v[192:195], v[144:159]
    s_waitcnt lgkmcnt(8)
    v_mfma_f32_32x32x16_bf16 v[144:159], v[108:111], v[196:199], v[144:159]
    s_nop 7
    v_cvt_pk_bf16_f32 v64, v128, v129
    v_cvt_pk_bf16_f32 v65, v130, v131
    ds_write_b64 v200, v[64:65] offset:0
    v_cvt_pk_bf16_f32 v66, v132, v133
    v_cvt_pk_bf16_f32 v67, v134, v135
    ds_write_b64 v201, v[66:67] offset:0
    s_waitcnt lgkmcnt(8)
    v_mfma_f32_32x32x16_bf16 v[160:175], v[112:115], v[192:195], v[160:175]
    v_cvt_pk_bf16_f32 v68, v136, v137
    v_cvt_pk_bf16_f32 v69, v138, v139
    ds_write_b64 v202, v[68:69] offset:0
    v_cvt_pk_bf16_f32 v70, v140, v141
    v_cvt_pk_bf16_f32 v71, v142, v143
    ds_write_b64 v203, v[70:71] offset:0
    s_waitcnt lgkmcnt(8)
    v_mfma_f32_32x32x16_bf16 v[160:175], v[116:119], v[196:199], v[160:175]
    v_cvt_pk_bf16_f32 v72, v144, v145
    v_cvt_pk_bf16_f32 v73, v146, v147
    ds_write_b64 v204, v[72:73] offset:0
    v_cvt_pk_bf16_f32 v74, v148, v149
    v_cvt_pk_bf16_f32 v75, v150, v151
    ds_write_b64 v205, v[74:75] offset:0
    s_waitcnt lgkmcnt(8)
    v_mfma_f32_32x32x16_bf16 v[176:191], v[120:123], v[192:195], v[176:191]
    v_cvt_pk_bf16_f32 v76, v152, v153
    v_cvt_pk_bf16_f32 v77, v154, v155
    ds_write_b64 v206, v[76:77] offset:0
    v_cvt_pk_bf16_f32 v78, v156, v157
    v_cvt_pk_bf16_f32 v79, v158, v159
    ds_write_b64 v207, v[78:79] offset:0
    s_waitcnt lgkmcnt(8)
    v_mfma_f32_32x32x16_bf16 v[176:191], v[124:127], v[196:199], v[176:191]
    ds_read_b128 v[16:19], v240 offset:0
    ds_read_b128 v[20:23], v240 offset:1024
    ds_read_b128 v[24:27], v240 offset:2048
    ds_read_b128 v[28:31], v240 offset:3072
    v_cvt_pk_bf16_f32 v80, v160, v161
    v_cvt_pk_bf16_f32 v81, v162, v163
    ds_write_b64 v200, v[80:81] offset:4096
    v_cvt_pk_bf16_f32 v82, v164, v165
    v_cvt_pk_bf16_f32 v83, v166, v167
    ds_write_b64 v201, v[82:83] offset:4096
    v_cvt_pk_bf16_f32 v84, v168, v169
    v_cvt_pk_bf16_f32 v85, v170, v171
    ds_write_b64 v202, v[84:85] offset:4096
    v_cvt_pk_bf16_f32 v86, v172, v173
    v_cvt_pk_bf16_f32 v87, v174, v175
    ds_write_b64 v203, v[86:87] offset:4096
    s_waitcnt lgkmcnt(7)
    buffer_store_dwordx4 v[16:19], v238, s[32:35], 0 offen offset:0
    s_waitcnt lgkmcnt(6)
    buffer_store_dwordx4 v[20:23], v238, s[32:35], 0 offen offset:2048
    v_cvt_pk_bf16_f32 v88, v176, v177
    v_cvt_pk_bf16_f32 v89, v178, v179
    ds_write_b64 v204, v[88:89] offset:4096
    v_cvt_pk_bf16_f32 v90, v180, v181
    v_cvt_pk_bf16_f32 v91, v182, v183
    ds_write_b64 v205, v[90:91] offset:4096
    v_cvt_pk_bf16_f32 v92, v184, v185
    v_cvt_pk_bf16_f32 v93, v186, v187
    ds_write_b64 v206, v[92:93] offset:4096
    v_cvt_pk_bf16_f32 v94, v188, v189
    v_cvt_pk_bf16_f32 v95, v190, v191
    ds_write_b64 v207, v[94:95] offset:4096
    ds_read_b128 v[32:35], v240 offset:4096
    ds_read_b128 v[36:39], v240 offset:5120
    ds_read_b128 v[40:43], v240 offset:6144
    ds_read_b128 v[44:47], v240 offset:7168
    s_waitcnt lgkmcnt(13)
    buffer_store_dwordx4 v[24:27], v238, s[32:35], s51 offen offset:0
    s_waitcnt lgkmcnt(12)
    buffer_store_dwordx4 v[28:31], v238, s[32:35], s51 offen offset:2048
    s_waitcnt lgkmcnt(3)
    buffer_store_dwordx4 v[32:35], v238, s[32:35], 0 offen offset:128
    s_waitcnt lgkmcnt(2)
    buffer_store_dwordx4 v[36:39], v238, s[32:35], 0 offen offset:2176
    s_waitcnt lgkmcnt(1)
    buffer_store_dwordx4 v[40:43], v238, s[32:35], s51 offen offset:128
    s_waitcnt lgkmcnt(0)
    buffer_store_dwordx4 v[44:47], v238, s[32:35], s51 offen offset:2176
    s_endpgm
L_qkbA:
    v_mfma_f32_32x32x16_bf16 v[48:63], v[64:67], v[16:19], v[208:223]
    s_branch L_qkrA
L_qkbB:
    v_mfma_f32_32x32x16_bf16 v[48:63], v[64:67], v[16:19], v[208:223]
    s_branch L_qkrB
L_zeroq:
    v_mov_b32 v16, 0
    v_mov_b32 v17, 0
    v_mov_b32 v18, 0
    v_mov_b32 v19, 0
    v_mov_b32 v20, 0
    v_mov_b32 v21, 0
    v_mov_b32 v22, 0
    v_mov_b32 v23, 0
    v_mov_b32 v24, 0
    v_mov_b32 v25, 0
    v_mov_b32 v26, 0
    v_mov_b32 v27, 0
    v_mov_b32 v28, 0
    v_mov_b32 v29, 0
    v_mov_b32 v30, 0
    v_mov_b32 v31, 0
    v_mov_b32 v32, 0
    v_mov_b32 v33, 0
    v_mov_b32 v34, 0
    v_mov_b32 v35, 0
    v_mov_b32 v36, 0
    v_mov_b32 v37, 0
    v_mov_b32 v38, 0
    v_mov_b32 v39, 0
    v_mov_b32 v40, 0
    v_mov_b32 v41, 0
    v_mov_b32 v42, 0
    v_mov_b32 v43, 0
    v_mov_b32 v44, 0
    v_mov_b32 v45, 0
    v_mov_b32 v46, 0
    v_mov_b32 v47, 0
    s_branch L_first
L_ctrl:
    s_lshr_b32 s26, 0x7ce42b9, s20
    s_lshr_b32 s27, 0xa35fd861, s20
    s_and_b32 s26, s26, 15
    s_and_b32 s27, s27, 15
    s_lshl_b32 s26, s26, 2
    s_lshl_b32 s27, s27, 2
    v_mov_b32 v6, 131072
    v_and_b32 v0, 63, v0
    v_and_b32 v8, 31, v0
    v_lshlrev_b32 v8, 2, v8
    s_lshl_b32 s43, s20, 2
    s_mov_b32 s44, s20
    s_add_u32 s43, s43, s21
    v_mov_b32 v9, s43
    s_waitcnt lgkmcnt(0)
    s_load_dword s36, s[12:13], s26
    s_load_dword s37, s[12:13], s27
    global_load_dword v15, v8, s[16:17]
    v_and_b32 v10, 3, v0
    v_mov_b32 v11, 0xffffff00
    v_cmp_eq_u32 vcc, 0, v10
    s_nop 1
    v_cndmask_b32 v10, -1, v11, vcc
    v_cmp_gt_u32 vcc, 32, v0
    s_nop 1
    v_cndmask_b32 v10, 0, v10, vcc
    s_mov_b32 s46, 0
    s_waitcnt lgkmcnt(0)
    s_sub_u32 s36, s36, 1
    s_min_u32 s36, s36, 0x7ff
    s_lshr_b32 s36, s36, 5
    s_sub_u32 s37, s37, 1
    s_min_u32 s37, s37, 0x7ff
    s_lshr_b32 s37, s37, 5
    s_add_u32 s36, s36, s37
    s_sub_u32 s36, s36, 90
    s_mov_b32 s38, 1
L_ms:
    s_mov_b32 s39, 2097152
L_mspoll:
    ds_read_b32 v7, v6
    s_sub_u32 s39, s39, 1
    s_cbranch_scc1 L_end
    s_waitcnt lgkmcnt(0)
    v_readfirstlane_b32 s40, v7
    s_bfe_u32 s41, s40, 0x80008
    s_lshr_b32 s40, s40, 24
    s_add_u32 s40, s40, s41
    s_cmp_ge_i32 s40, s36
    s_cbranch_scc0 L_mspoll
    s_sub_u32 s40, s40, s36
    s_lshr_b32 s40, s40, 1
    s_add_u32 s38, s38, s40
    s_lshl_b32 s40, s40, 1
    s_add_u32 s36, s36, s40
    v_mov_b32 v4, s38
    global_load_dword v5, v8, s[16:17] nt
    s_add_u32 s36, s36, 2
    s_sub_u32 s41, s21, 1
    s_cmp_ge_u32 s41, 15
    s_cbranch_scc1 L_nopub
    s_mov_b64 exec, 1
    global_store_byte v9, v4, s[16:17]
    s_mov_b64 exec, -1
    s_waitcnt vmcnt(1)
L_count:
    v_readlane_b32 s41, v5, s44
    v_and_b32 v5, v10, v5
    v_cmp_ge_u32_sdwa s[48:49], v5, v4 src0_sel:BYTE_0 src1_sel:DWORD
    v_cmp_ge_u32_sdwa s[50:51], v5, v4 src0_sel:BYTE_1 src1_sel:DWORD
    v_cmp_ge_u32_sdwa s[52:53], v5, v4 src0_sel:BYTE_2 src1_sel:DWORD
    v_cmp_ge_u32_sdwa s[54:55], v5, v4 src0_sel:BYTE_3 src1_sel:DWORD
    s_and_b32 s41, s41, 0xff
    s_mul_i32 s42, s41, 3
    s_sub_u32 s42, s42, 13
    s_ashr_i32 s42, s42, 1
    s_cmp_eq_u32 s41, 0
    s_cselect_b32 s42, 0, s42
    s_bcnt1_i32_b64 s41, s[48:49]
    s_lshl1_add_u32 s42, s41, s42
    s_bcnt1_i32_b64 s41, s[50:51]
    s_lshl1_add_u32 s42, s41, s42
    s_bcnt1_i32_b64 s41, s[52:53]
    s_lshl1_add_u32 s42, s41, s42
    s_bcnt1_i32_b64 s41, s[54:55]
    s_lshl1_add_u32 s42, s41, s42
    s_add_u32 s42, s42, 3
    s_max_i32 s42, s42, 0
    s_mul_i32 s42, s42, 5
    s_lshr_b32 s42, s42, 5
    s_min_u32 s42, s42, 4
    s_lshl_b32 s42, s42, 2
    s_mov_b32 s41, 0x43210
    s_lshr_b32 s42, s41, s42
    s_and_b32 s42, s42, 15
    v_mov_b32 v5, s42
    ds_write_b32 v6, v5 offset:24
    s_cmp_eq_u32 s21, 0
    s_cbranch_scc1 L_rep
L_repd:
    s_add_u32 s38, s38, 1
    s_cmp_le_u32 s38, 46
    s_cbranch_scc1 L_ms
    s_waitcnt lgkmcnt(0)
    s_endpgm
L_nopub:
    s_waitcnt vmcnt(0)
    s_branch L_count
L_rep:
    s_min_u32 s47, s38, 46
    s_sub_u32 s47, 63, s47
    s_mov_b32 s60, 0x82280000
    s_mov_b32 s61, 0x808080
    s_lshr_b64 s[60:61], s[60:61], s47
    s_bcnt1_i32_b64 s47, s[60:61]
    s_cmp_eq_u32 s46, s47
    s_cbranch_scc1 L_repd
    s_mov_b32 s46, s47
    s_lshl2_add_u32 s47, s47, 0x80
    s_mov_b32 s42, 1
    s_atomic_add s42, s[16:17], s47 glc
    s_waitcnt lgkmcnt(0)
    s_min_u32 s42, s42, 7
    s_add_u32 s42, s42, 1
    v_mov_b32 v14, s42
    s_mov_b64 exec, 1
    global_store_byte v9, v14, s[16:17]
    s_mov_b64 exec, -1
    s_branch L_repd
L_end:
    s_endpgm
.section .rodata,"a"
.p2align 6
.amdhsa_kernel standalone__paged_block_table_kv_pagedattention__sampling_kernel
  .amdhsa_next_free_vgpr 256
  .amdhsa_next_free_sgpr 102
  .amdhsa_accum_offset 256
  .amdhsa_group_segment_fixed_size 0
  .amdhsa_kernarg_size 64
  .amdhsa_user_sgpr_count 2
  .amdhsa_user_sgpr_kernarg_segment_ptr 1
  .amdhsa_system_sgpr_workgroup_id_x 1
.end_amdhsa_kernel
```
